```python
import torch

def _softmax(x, axis=-1):
    return torch.softmax(x, dim=axis)
def _gelu(x):
    return torch.nn.functional.gelu(x, approximate="tanh")
def _silu(x):
    return torch.nn.functional.silu(x)
def _sigmoid(x):
    return torch.sigmoid(x)
def _layernorm(x, axis=-1, eps=1e-5):
    m = x.mean(dim=axis, keepdim=True)
    v = x.var(dim=axis, keepdim=True, unbiased=False)
    return (x - m) / torch.sqrt(v + eps)
def _scatter_add(tgt, idx, src, axis=0):
    return tgt.clone().index_add_(axis, idx, src)
def _segment_sum(src, seg, n):
    out = torch.zeros((n,) + src.shape[1:], dtype=src.dtype)
    return out.index_add_(0, seg, src)
def _pad(x, pw):
    flat = tuple(v for pair in reversed(pw) for v in pair)
    return torch.nn.functional.pad(x, flat)

kernel_name = 'standalone__low_rank_proj_linformer__decode'

def setup_inputs():

    _w = (lambda a: (lambda t: t.to(torch.bfloat16) if t.is_floating_point() else t)(torch.as_tensor(a)))
    B, H, Sq, Skv, Dh, R = 1, 32, 1, 65536, 128, 16
    return {
        "q": _w((lambda *s: torch.randn(*s, dtype=torch.bfloat16) * 0.8)(B, H, Sq, Dh)),
        "k": _w((lambda *s: torch.randn(*s, dtype=torch.bfloat16) * 0.8)(B, H, Skv, Dh)),
        "v": _w((lambda *s: torch.randn(*s, dtype=torch.bfloat16) * 0.05)(B, H, Skv, Dh)),
        "e_proj": _w((lambda *s: torch.randn(*s, dtype=torch.bfloat16) * 0.8)(R, Skv) * (Skv ** -0.5)),
        "f_proj": _w((lambda *s: torch.randn(*s, dtype=torch.bfloat16) * 0.05)(R, Skv) * (Skv ** -0.5)),
    }

def reference(q, k, v, e_proj, f_proj):
    B, H, Sq, Dh = q.shape
    kp = torch.einsum("rn,bhnd->bhrd", e_proj, k)
    vp = torch.einsum("rn,bhnd->bhrd", f_proj, v)
    scores = torch.einsum("bhqd,bhrd->bhqr", q, kp) * (Dh ** -0.5)
    p = _softmax(scores, axis=-1)
    o = torch.einsum("bhqr,bhrd->bhqd", p, vp)
    return o
```

```asm
; @launch grid=(256,1,1) block=(320,1,1) lds=4480
.amdgcn_target "amdgcn-amd-amdhsa--gfx950"
.text
.globl standalone__low_rank_proj_linformer__decode_kernel
.p2align 8
.type standalone__low_rank_proj_linformer__decode_kernel,@function
standalone__low_rank_proj_linformer__decode_kernel:
    s_cmp_ge_u32 s2, 256
    s_cbranch_scc1 L_end
    s_load_dwordx16 s[4:19], s[0:1], 0
    v_lshrrev_b32 v3, 6, v0
    v_and_b32 v0, 63, v0
    v_readfirstlane_b32 s3, v3
    s_and_b32 s42, s2, 7
    s_lshr_b32 s39, s2, 3
    v_and_b32 v3, 15, v0
    v_lshrrev_b32 v8, 4, v0
    s_cmp_eq_u32 s3, 4
    s_cbranch_scc1 L_ctrl
    s_setprio 2
    v_lshlrev_b32 v1, 11, v8
    v_lshl_add_u32 v1, v3, 4, v1
    v_lshlrev_b32 v2, 17, v3
    v_lshl_add_u32 v2, v8, 4, v2
    v_lshlrev_b32 v9, 4, v3
    s_mov_b32 s40, 0x05040100
    s_mov_b32 s41, 0x07060302
    s_lshl_b32 s56, s3, 13
    s_lshl_b32 s52, s42, 21
    s_add_u32 s52, s52, s56
    s_mov_b32 s36, s52
    s_lshr_b32 s37, s36, 7
    s_lshl_b32 s44, s39, 24
    s_lshl_b32 s45, s39, 8
    s_waitcnt lgkmcnt(0)
    s_add_u32 s20, s6, s44
    s_addc_u32 s21, s7, 0
    s_and_b32 s21, s21, 0xffff
    s_mov_b32 s22, 16777216
    s_mov_b32 s23, 0x20000
    buffer_load_dwordx4 v[52:55], v1, s[20:23], s36 offen offset:0 nt
    buffer_load_dwordx4 v[56:59], v1, s[20:23], s36 offen offset:256 nt
    buffer_load_dwordx4 v[60:63], v1, s[20:23], s36 offen offset:512 nt
    buffer_load_dwordx4 v[64:67], v1, s[20:23], s36 offen offset:768 nt
    buffer_load_dwordx4 v[68:71], v1, s[20:23], s36 offen offset:1024 nt
    s_mov_b32 s28, s10
    s_and_b32 s29, s11, 0xffff
    s_mov_b32 s30, 2097152
    s_mov_b32 s31, 0x20000
    s_add_u32 s48, s4, s45
    s_addc_u32 s49, s5, 0
    s_and_b32 s49, s49, 0xffff
    s_mov_b32 s50, 256
    s_mov_b32 s51, 0x20000
    s_add_u32 s24, s8, s44
    s_addc_u32 s25, s9, 0
    s_and_b32 s25, s25, 0xffff
    s_mov_b32 s26, 16777216
    s_mov_b32 s27, 0x20000
    s_mov_b32 s32, s12
    s_and_b32 s33, s13, 0xffff
    s_mov_b32 s34, 2097152
    s_mov_b32 s35, 0x20000
    buffer_load_dwordx4 v[148:151], v2, s[28:31], s37 offen
    buffer_load_dwordx4 v[4:7], v9, s[48:51], 0 offen
    v_mov_b32 v20, 0
    v_mov_b32 v21, 0
    v_mov_b32 v22, 0
    v_mov_b32 v23, 0
    v_mov_b32 v24, 0
    v_mov_b32 v25, 0
    v_mov_b32 v26, 0
    v_mov_b32 v27, 0
    v_mov_b32 v28, 0
    v_mov_b32 v29, 0
    v_mov_b32 v30, 0
    v_mov_b32 v31, 0
    v_mov_b32 v32, 0
    v_mov_b32 v33, 0
    v_mov_b32 v34, 0
    v_mov_b32 v35, 0
    v_mov_b32 v36, 0
    v_mov_b32 v37, 0
    v_mov_b32 v38, 0
    v_mov_b32 v39, 0
    v_mov_b32 v40, 0
    v_mov_b32 v41, 0
    v_mov_b32 v42, 0
    v_mov_b32 v43, 0
    v_mov_b32 v44, 0
    v_mov_b32 v45, 0
    v_mov_b32 v46, 0
    v_mov_b32 v47, 0
    v_mov_b32 v48, 0
    v_mov_b32 v49, 0
    v_mov_b32 v50, 0
    v_mov_b32 v51, 0
    v_mov_b32 v157, 2432
    v_mov_b32 v159, 2376
    s_mov_b32 s53, 2
    s_mov_b32 s54, 0
    s_mov_b32 s57, 0
    s_mov_b32 s60, 0
    s_barrier
    s_waitcnt vmcnt(6)
    buffer_load_dwordx4 v[72:75], v1, s[20:23], s36 offen offset:1280 nt
    buffer_load_dwordx4 v[76:79], v1, s[20:23], s36 offen offset:1536 nt
    s_waitcnt vmcnt(7)
    v_perm_b32 v84, v56, v52, s40
    v_perm_b32 v88, v56, v52, s41
    v_perm_b32 v92, v57, v53, s40
    v_perm_b32 v96, v57, v53, s41
    v_perm_b32 v100, v58, v54, s40
    v_perm_b32 v104, v58, v54, s41
    v_perm_b32 v108, v59, v55, s40
    v_perm_b32 v112, v59, v55, s41
    s_waitcnt vmcnt(6)
    buffer_load_dwordx4 v[80:83], v1, s[20:23], s36 offen offset:1792 nt
    s_add_u32 s36, s36, 32768
    s_lshr_b32 s37, s36, 7
    s_waitcnt vmcnt(6)
    buffer_load_dwordx4 v[52:55], v1, s[20:23], s36 offen offset:0 nt
    v_perm_b32 v85, v64, v60, s40
    v_perm_b32 v89, v64, v60, s41
    v_perm_b32 v93, v65, v61, s40
    v_perm_b32 v97, v65, v61, s41
    v_perm_b32 v101, v66, v62, s40
    v_perm_b32 v105, v66, v62, s41
    v_perm_b32 v109, v67, v63, s40
    v_perm_b32 v113, v67, v63, s41
    s_waitcnt vmcnt(6)
    buffer_load_dwordx4 v[56:59], v1, s[20:23], s36 offen offset:256 nt
    buffer_load_dwordx4 v[60:63], v1, s[20:23], s36 offen offset:512 nt
    s_waitcnt vmcnt(5)
    v_perm_b32 v86, v72, v68, s40
    v_perm_b32 v90, v72, v68, s41
    v_perm_b32 v94, v73, v69, s40
    v_perm_b32 v98, v73, v69, s41
    v_perm_b32 v102, v74, v70, s40
    v_perm_b32 v106, v74, v70, s41
    v_perm_b32 v110, v75, v71, s40
    v_perm_b32 v114, v75, v71, s41
    s_waitcnt vmcnt(4)
    buffer_load_dwordx4 v[64:67], v1, s[20:23], s36 offen offset:768 nt
    s_waitcnt vmcnt(4)
    buffer_load_dwordx4 v[68:71], v1, s[20:23], s36 offen offset:1024 nt
    v_perm_b32 v87, v80, v76, s40
    v_perm_b32 v91, v80, v76, s41
    v_perm_b32 v95, v81, v77, s40
    v_perm_b32 v99, v81, v77, s41
    v_perm_b32 v103, v82, v78, s40
    v_perm_b32 v107, v82, v78, s41
    v_perm_b32 v111, v83, v79, s40
    v_perm_b32 v115, v83, v79, s41
    buffer_load_dwordx4 v[152:155], v2, s[28:31], s37 offen
    s_waitcnt vmcnt(5)
    buffer_load_dwordx4 v[72:75], v1, s[20:23], s36 offen offset:1280 nt
    buffer_load_dwordx4 v[76:79], v1, s[20:23], s36 offen offset:1536 nt
    v_mfma_f32_16x16x32_bf16 v[20:23], v[148:151], v[84:87], v[20:23]
    s_waitcnt vmcnt(6)
    v_perm_b32 v116, v56, v52, s40
    v_perm_b32 v120, v56, v52, s41
    v_perm_b32 v124, v57, v53, s40
    v_perm_b32 v128, v57, v53, s41
    v_perm_b32 v132, v58, v54, s40
    v_perm_b32 v136, v58, v54, s41
    v_perm_b32 v140, v59, v55, s40
    v_perm_b32 v144, v59, v55, s41
    v_mfma_f32_16x16x32_bf16 v[24:27], v[148:151], v[88:91], v[24:27]
    s_waitcnt vmcnt(5)
    buffer_load_dwordx4 v[80:83], v1, s[20:23], s36 offen offset:1792 nt
    v_mfma_f32_16x16x32_bf16 v[28:31], v[148:151], v[92:95], v[28:31]
    s_add_u32 s36, s36, 32768
    s_lshr_b32 s37, s36, 7
    s_waitcnt vmcnt(5)
    buffer_load_dwordx4 v[52:55], v1, s[20:23], s36 offen offset:0 nt
    v_perm_b32 v117, v64, v60, s40
    v_perm_b32 v121, v64, v60, s41
    v_perm_b32 v125, v65, v61, s40
    v_perm_b32 v129, v65, v61, s41
    v_perm_b32 v133, v66, v62, s40
    v_perm_b32 v137, v66, v62, s41
    v_perm_b32 v141, v67, v63, s40
    v_perm_b32 v145, v67, v63, s41
    v_mfma_f32_16x16x32_bf16 v[32:35], v[148:151], v[96:99], v[32:35]
    s_waitcnt vmcnt(5)
    buffer_load_dwordx4 v[56:59], v1, s[20:23], s36 offen offset:256 nt
    buffer_load_dwordx4 v[60:63], v1, s[20:23], s36 offen offset:512 nt
    v_mfma_f32_16x16x32_bf16 v[36:39], v[148:151], v[100:103], v[36:39]
    s_waitcnt vmcnt(5)
    v_perm_b32 v118, v72, v68, s40
    v_perm_b32 v122, v72, v68, s41
    v_perm_b32 v126, v73, v69, s40
    v_perm_b32 v130, v73, v69, s41
    v_perm_b32 v134, v74, v70, s40
    v_perm_b32 v138, v74, v70, s41
    v_perm_b32 v142, v75, v71, s40
    v_perm_b32 v146, v75, v71, s41
    v_mfma_f32_16x16x32_bf16 v[40:43], v[148:151], v[104:107], v[40:43]
    s_waitcnt vmcnt(4)
    buffer_load_dwordx4 v[64:67], v1, s[20:23], s36 offen offset:768 nt
    v_mfma_f32_16x16x32_bf16 v[44:47], v[148:151], v[108:111], v[44:47]
    s_waitcnt vmcnt(4)
    buffer_load_dwordx4 v[68:71], v1, s[20:23], s36 offen offset:1024 nt
    v_perm_b32 v119, v80, v76, s40
    v_perm_b32 v123, v80, v76, s41
    v_perm_b32 v127, v81, v77, s40
    v_perm_b32 v131, v81, v77, s41
    v_perm_b32 v135, v82, v78, s40
    v_perm_b32 v139, v82, v78, s41
    v_perm_b32 v143, v83, v79, s40
    v_perm_b32 v147, v83, v79, s41
    v_mfma_f32_16x16x32_bf16 v[48:51], v[148:151], v[112:115], v[48:51]
    buffer_load_dwordx4 v[148:151], v2, s[28:31], s37 offen
    s_mov_b32 s38, 30
L_k_loop_a:
    s_waitcnt vmcnt(5)
    buffer_load_dwordx4 v[72:75], v1, s[20:23], s36 offen offset:1280 nt
    buffer_load_dwordx4 v[76:79], v1, s[20:23], s36 offen offset:1536 nt
    v_mfma_f32_16x16x32_bf16 v[20:23], v[152:155], v[116:119], v[20:23]
    s_waitcnt vmcnt(6)
    v_perm_b32 v84, v56, v52, s40
    v_perm_b32 v88, v56, v52, s41
    v_perm_b32 v92, v57, v53, s40
    v_perm_b32 v96, v57, v53, s41
    v_perm_b32 v100, v58, v54, s40
    v_perm_b32 v104, v58, v54, s41
    v_perm_b32 v108, v59, v55, s40
    v_perm_b32 v112, v59, v55, s41
    v_mfma_f32_16x16x32_bf16 v[24:27], v[152:155], v[120:123], v[24:27]
    s_waitcnt vmcnt(5)
    buffer_load_dwordx4 v[80:83], v1, s[20:23], s36 offen offset:1792 nt
    v_mfma_f32_16x16x32_bf16 v[28:31], v[152:155], v[124:127], v[28:31]
    s_add_u32 s36, s36, 32768
    s_lshr_b32 s37, s36, 7
    s_waitcnt vmcnt(5)
    buffer_load_dwordx4 v[52:55], v1, s[20:23], s36 offen offset:0 nt
    v_perm_b32 v85, v64, v60, s40
    v_perm_b32 v89, v64, v60, s41
    v_perm_b32 v93, v65, v61, s40
    v_perm_b32 v97, v65, v61, s41
    v_perm_b32 v101, v66, v62, s40
    v_perm_b32 v105, v66, v62, s41
    v_perm_b32 v109, v67, v63, s40
    v_perm_b32 v113, v67, v63, s41
    v_mfma_f32_16x16x32_bf16 v[32:35], v[152:155], v[128:131], v[32:35]
    s_waitcnt vmcnt(5)
    buffer_load_dwordx4 v[56:59], v1, s[20:23], s36 offen offset:256 nt
    buffer_load_dwordx4 v[60:63], v1, s[20:23], s36 offen offset:512 nt
    v_mfma_f32_16x16x32_bf16 v[36:39], v[152:155], v[132:135], v[36:39]
    s_waitcnt vmcnt(5)
    v_perm_b32 v86, v72, v68, s40
    v_perm_b32 v90, v72, v68, s41
    v_perm_b32 v94, v73, v69, s40
    v_perm_b32 v98, v73, v69, s41
    v_perm_b32 v102, v74, v70, s40
    v_perm_b32 v106, v74, v70, s41
    v_perm_b32 v110, v75, v71, s40
    v_perm_b32 v114, v75, v71, s41
    v_mfma_f32_16x16x32_bf16 v[40:43], v[152:155], v[136:139], v[40:43]
    s_waitcnt vmcnt(4)
    buffer_load_dwordx4 v[64:67], v1, s[20:23], s36 offen offset:768 nt
    v_mfma_f32_16x16x32_bf16 v[44:47], v[152:155], v[140:143], v[44:47]
    s_waitcnt vmcnt(4)
    buffer_load_dwordx4 v[68:71], v1, s[20:23], s36 offen offset:1024 nt
    v_perm_b32 v87, v80, v76, s40
    v_perm_b32 v91, v80, v76, s41
    v_perm_b32 v95, v81, v77, s40
    v_perm_b32 v99, v81, v77, s41
    v_perm_b32 v103, v82, v78, s40
    v_perm_b32 v107, v82, v78, s41
    v_perm_b32 v111, v83, v79, s40
    v_perm_b32 v115, v83, v79, s41
    v_mfma_f32_16x16x32_bf16 v[48:51], v[152:155], v[144:147], v[48:51]
    buffer_load_dwordx4 v[152:155], v2, s[28:31], s37 offen
    s_waitcnt vmcnt(5)
    buffer_load_dwordx4 v[72:75], v1, s[20:23], s36 offen offset:1280 nt
    buffer_load_dwordx4 v[76:79], v1, s[20:23], s36 offen offset:1536 nt
    v_mfma_f32_16x16x32_bf16 v[20:23], v[148:151], v[84:87], v[20:23]
    s_waitcnt vmcnt(6)
    v_perm_b32 v116, v56, v52, s40
    v_perm_b32 v120, v56, v52, s41
    v_perm_b32 v124, v57, v53, s40
    v_perm_b32 v128, v57, v53, s41
    v_perm_b32 v132, v58, v54, s40
    v_perm_b32 v136, v58, v54, s41
    v_perm_b32 v140, v59, v55, s40
    v_perm_b32 v144, v59, v55, s41
    v_mfma_f32_16x16x32_bf16 v[24:27], v[148:151], v[88:91], v[24:27]
    s_waitcnt vmcnt(5)
    buffer_load_dwordx4 v[80:83], v1, s[20:23], s36 offen offset:1792 nt
    v_mfma_f32_16x16x32_bf16 v[28:31], v[148:151], v[92:95], v[28:31]
    s_add_u32 s36, s36, 32768
    s_lshr_b32 s37, s36, 7
    s_waitcnt vmcnt(5)
    buffer_load_dwordx4 v[52:55], v1, s[20:23], s36 offen offset:0 nt
    v_perm_b32 v117, v64, v60, s40
    v_perm_b32 v121, v64, v60, s41
    v_perm_b32 v125, v65, v61, s40
    v_perm_b32 v129, v65, v61, s41
    v_perm_b32 v133, v66, v62, s40
    v_perm_b32 v137, v66, v62, s41
    v_perm_b32 v141, v67, v63, s40
    v_perm_b32 v145, v67, v63, s41
    v_mfma_f32_16x16x32_bf16 v[32:35], v[148:151], v[96:99], v[32:35]
    s_waitcnt vmcnt(5)
    buffer_load_dwordx4 v[56:59], v1, s[20:23], s36 offen offset:256 nt
    buffer_load_dwordx4 v[60:63], v1, s[20:23], s36 offen offset:512 nt
    v_mfma_f32_16x16x32_bf16 v[36:39], v[148:151], v[100:103], v[36:39]
    s_waitcnt vmcnt(5)
    v_perm_b32 v118, v72, v68, s40
    v_perm_b32 v122, v72, v68, s41
    v_perm_b32 v126, v73, v69, s40
    v_perm_b32 v130, v73, v69, s41
    v_perm_b32 v134, v74, v70, s40
    v_perm_b32 v138, v74, v70, s41
    v_perm_b32 v142, v75, v71, s40
    v_perm_b32 v146, v75, v71, s41
    v_mfma_f32_16x16x32_bf16 v[40:43], v[148:151], v[104:107], v[40:43]
    s_waitcnt vmcnt(4)
    buffer_load_dwordx4 v[64:67], v1, s[20:23], s36 offen offset:768 nt
    v_mfma_f32_16x16x32_bf16 v[44:47], v[148:151], v[108:111], v[44:47]
    s_waitcnt vmcnt(4)
    buffer_load_dwordx4 v[68:71], v1, s[20:23], s36 offen offset:1024 nt
    v_perm_b32 v119, v80, v76, s40
    v_perm_b32 v123, v80, v76, s41
    v_perm_b32 v127, v81, v77, s40
    v_perm_b32 v131, v81, v77, s41
    v_perm_b32 v135, v82, v78, s40
    v_perm_b32 v139, v82, v78, s41
    v_perm_b32 v143, v83, v79, s40
    v_perm_b32 v147, v83, v79, s41
    v_mfma_f32_16x16x32_bf16 v[48:51], v[148:151], v[112:115], v[48:51]
    buffer_load_dwordx4 v[148:151], v2, s[28:31], s37 offen
    s_sub_u32 s38, s38, 1
    s_cmp_lg_u32 s38, 0
    s_cbranch_scc1 L_k_loop_a
    s_waitcnt vmcnt(5)
    buffer_load_dwordx4 v[72:75], v1, s[20:23], s36 offen offset:1280 nt
    buffer_load_dwordx4 v[76:79], v1, s[20:23], s36 offen offset:1536 nt
    v_mfma_f32_16x16x32_bf16 v[20:23], v[152:155], v[116:119], v[20:23]
    s_waitcnt vmcnt(6)
    v_perm_b32 v84, v56, v52, s40
    v_perm_b32 v88, v56, v52, s41
    v_perm_b32 v92, v57, v53, s40
    v_perm_b32 v96, v57, v53, s41
    v_perm_b32 v100, v58, v54, s40
    v_perm_b32 v104, v58, v54, s41
    v_perm_b32 v108, v59, v55, s40
    v_perm_b32 v112, v59, v55, s41
    v_mfma_f32_16x16x32_bf16 v[24:27], v[152:155], v[120:123], v[24:27]
    s_waitcnt vmcnt(5)
    buffer_load_dwordx4 v[80:83], v1, s[20:23], s36 offen offset:1792 nt
    v_mfma_f32_16x16x32_bf16 v[28:31], v[152:155], v[124:127], v[28:31]
    s_add_u32 s36, s36, 32768
    s_lshr_b32 s37, s36, 7
    s_waitcnt vmcnt(5)
    buffer_load_dwordx4 v[52:55], v1, s[20:23], s36 offen offset:0 nt
    v_perm_b32 v85, v64, v60, s40
    v_perm_b32 v89, v64, v60, s41
    v_perm_b32 v93, v65, v61, s40
    v_perm_b32 v97, v65, v61, s41
    v_perm_b32 v101, v66, v62, s40
    v_perm_b32 v105, v66, v62, s41
    v_perm_b32 v109, v67, v63, s40
    v_perm_b32 v113, v67, v63, s41
    v_mfma_f32_16x16x32_bf16 v[32:35], v[152:155], v[128:131], v[32:35]
    s_waitcnt vmcnt(5)
    buffer_load_dwordx4 v[56:59], v1, s[20:23], s36 offen offset:256 nt
    buffer_load_dwordx4 v[60:63], v1, s[20:23], s36 offen offset:512 nt
    v_mfma_f32_16x16x32_bf16 v[36:39], v[152:155], v[132:135], v[36:39]
    s_waitcnt vmcnt(5)
    v_perm_b32 v86, v72, v68, s40
    v_perm_b32 v90, v72, v68, s41
    v_perm_b32 v94, v73, v69, s40
    v_perm_b32 v98, v73, v69, s41
    v_perm_b32 v102, v74, v70, s40
    v_perm_b32 v106, v74, v70, s41
    v_perm_b32 v110, v75, v71, s40
    v_perm_b32 v114, v75, v71, s41
    v_mfma_f32_16x16x32_bf16 v[40:43], v[152:155], v[136:139], v[40:43]
    s_waitcnt vmcnt(4)
    buffer_load_dwordx4 v[64:67], v1, s[20:23], s36 offen offset:768 nt
    v_mfma_f32_16x16x32_bf16 v[44:47], v[152:155], v[140:143], v[44:47]
    s_waitcnt vmcnt(4)
    buffer_load_dwordx4 v[68:71], v1, s[20:23], s36 offen offset:1024 nt
    v_perm_b32 v87, v80, v76, s40
    v_perm_b32 v91, v80, v76, s41
    v_perm_b32 v95, v81, v77, s40
    v_perm_b32 v99, v81, v77, s41
    v_perm_b32 v103, v82, v78, s40
    v_perm_b32 v107, v82, v78, s41
    v_perm_b32 v111, v83, v79, s40
    v_perm_b32 v115, v83, v79, s41
    v_mfma_f32_16x16x32_bf16 v[48:51], v[152:155], v[144:147], v[48:51]
    buffer_load_dwordx4 v[152:155], v2, s[28:31], s37 offen
    s_waitcnt vmcnt(5)
    buffer_load_dwordx4 v[72:75], v1, s[20:23], s36 offen offset:1280 nt
    buffer_load_dwordx4 v[76:79], v1, s[20:23], s36 offen offset:1536 nt
    v_mfma_f32_16x16x32_bf16 v[20:23], v[148:151], v[84:87], v[20:23]
    s_waitcnt vmcnt(6)
    v_perm_b32 v116, v56, v52, s40
    v_perm_b32 v120, v56, v52, s41
    v_perm_b32 v124, v57, v53, s40
    v_perm_b32 v128, v57, v53, s41
    v_perm_b32 v132, v58, v54, s40
    v_perm_b32 v136, v58, v54, s41
    v_perm_b32 v140, v59, v55, s40
    v_perm_b32 v144, v59, v55, s41
    v_mfma_f32_16x16x32_bf16 v[24:27], v[148:151], v[88:91], v[24:27]
    s_waitcnt vmcnt(5)
    buffer_load_dwordx4 v[80:83], v1, s[20:23], s36 offen offset:1792 nt
    v_mfma_f32_16x16x32_bf16 v[28:31], v[148:151], v[92:95], v[28:31]
    s_mov_b32 s36, s52
    s_lshr_b32 s37, s36, 7
    s_waitcnt vmcnt(5)
    buffer_load_dwordx4 v[52:55], v1, s[24:27], s36 offen offset:0 nt
    v_perm_b32 v117, v64, v60, s40
    v_perm_b32 v121, v64, v60, s41
    v_perm_b32 v125, v65, v61, s40
    v_perm_b32 v129, v65, v61, s41
    v_perm_b32 v133, v66, v62, s40
    v_perm_b32 v137, v66, v62, s41
    v_perm_b32 v141, v67, v63, s40
    v_perm_b32 v145, v67, v63, s41
    v_mfma_f32_16x16x32_bf16 v[32:35], v[148:151], v[96:99], v[32:35]
    s_waitcnt vmcnt(5)
    buffer_load_dwordx4 v[56:59], v1, s[24:27], s36 offen offset:256 nt
    buffer_load_dwordx4 v[60:63], v1, s[24:27], s36 offen offset:512 nt
    v_mfma_f32_16x16x32_bf16 v[36:39], v[148:151], v[100:103], v[36:39]
    s_waitcnt vmcnt(5)
    v_perm_b32 v118, v72, v68, s40
    v_perm_b32 v122, v72, v68, s41
    v_perm_b32 v126, v73, v69, s40
    v_perm_b32 v130, v73, v69, s41
    v_perm_b32 v134, v74, v70, s40
    v_perm_b32 v138, v74, v70, s41
    v_perm_b32 v142, v75, v71, s40
    v_perm_b32 v146, v75, v71, s41
    v_mfma_f32_16x16x32_bf16 v[40:43], v[148:151], v[104:107], v[40:43]
    s_waitcnt vmcnt(4)
    buffer_load_dwordx4 v[64:67], v1, s[24:27], s36 offen offset:768 nt
    v_mfma_f32_16x16x32_bf16 v[44:47], v[148:151], v[108:111], v[44:47]
    s_waitcnt vmcnt(4)
    buffer_load_dwordx4 v[68:71], v1, s[24:27], s36 offen offset:1024 nt
    v_perm_b32 v119, v80, v76, s40
    v_perm_b32 v123, v80, v76, s41
    v_perm_b32 v127, v81, v77, s40
    v_perm_b32 v131, v81, v77, s41
    v_perm_b32 v135, v82, v78, s40
    v_perm_b32 v139, v82, v78, s41
    v_perm_b32 v143, v83, v79, s40
    v_perm_b32 v147, v83, v79, s41
    v_mfma_f32_16x16x32_bf16 v[48:51], v[148:151], v[112:115], v[48:51]
    buffer_load_dwordx4 v[148:151], v2, s[32:35], s37 offen
    s_waitcnt vmcnt(5)
    buffer_load_dwordx4 v[72:75], v1, s[24:27], s36 offen offset:1280 nt
    buffer_load_dwordx4 v[76:79], v1, s[24:27], s36 offen offset:1536 nt
    v_mfma_f32_16x16x32_bf16 v[20:23], v[152:155], v[116:119], v[20:23]
    s_waitcnt vmcnt(6)
    v_perm_b32 v84, v56, v52, s40
    v_perm_b32 v88, v56, v52, s41
    v_perm_b32 v92, v57, v53, s40
    v_perm_b32 v96, v57, v53, s41
    v_perm_b32 v100, v58, v54, s40
    v_perm_b32 v104, v58, v54, s41
    v_perm_b32 v108, v59, v55, s40
    v_perm_b32 v112, v59, v55, s41
    v_mfma_f32_16x16x32_bf16 v[24:27], v[152:155], v[120:123], v[24:27]
    s_waitcnt vmcnt(5)
    buffer_load_dwordx4 v[80:83], v1, s[24:27], s36 offen offset:1792 nt
    v_mfma_f32_16x16x32_bf16 v[28:31], v[152:155], v[124:127], v[28:31]
    s_add_u32 s36, s36, 32768
    s_lshr_b32 s37, s36, 7
    s_waitcnt vmcnt(5)
    buffer_load_dwordx4 v[52:55], v1, s[24:27], s36 offen offset:0 nt
    v_perm_b32 v85, v64, v60, s40
    v_perm_b32 v89, v64, v60, s41
    v_perm_b32 v93, v65, v61, s40
    v_perm_b32 v97, v65, v61, s41
    v_perm_b32 v101, v66, v62, s40
    v_perm_b32 v105, v66, v62, s41
    v_perm_b32 v109, v67, v63, s40
    v_perm_b32 v113, v67, v63, s41
    v_mfma_f32_16x16x32_bf16 v[32:35], v[152:155], v[128:131], v[32:35]
    s_waitcnt vmcnt(5)
    buffer_load_dwordx4 v[56:59], v1, s[24:27], s36 offen offset:256 nt
    buffer_load_dwordx4 v[60:63], v1, s[24:27], s36 offen offset:512 nt
    v_mfma_f32_16x16x32_bf16 v[36:39], v[152:155], v[132:135], v[36:39]
    s_waitcnt vmcnt(5)
    v_perm_b32 v86, v72, v68, s40
    v_perm_b32 v90, v72, v68, s41
    v_perm_b32 v94, v73, v69, s40
    v_perm_b32 v98, v73, v69, s41
    v_perm_b32 v102, v74, v70, s40
    v_perm_b32 v106, v74, v70, s41
    v_perm_b32 v110, v75, v71, s40
    v_perm_b32 v114, v75, v71, s41
    v_mfma_f32_16x16x32_bf16 v[40:43], v[152:155], v[136:139], v[40:43]
    s_waitcnt vmcnt(4)
    buffer_load_dwordx4 v[64:67], v1, s[24:27], s36 offen offset:768 nt
    v_mfma_f32_16x16x32_bf16 v[44:47], v[152:155], v[140:143], v[44:47]
    s_waitcnt vmcnt(4)
    buffer_load_dwordx4 v[68:71], v1, s[24:27], s36 offen offset:1024 nt
    v_perm_b32 v87, v80, v76, s40
    v_perm_b32 v91, v80, v76, s41
    v_perm_b32 v95, v81, v77, s40
    v_perm_b32 v99, v81, v77, s41
    v_perm_b32 v103, v82, v78, s40
    v_perm_b32 v107, v82, v78, s41
    v_perm_b32 v111, v83, v79, s40
    v_perm_b32 v115, v83, v79, s41
    v_mfma_f32_16x16x32_bf16 v[48:51], v[152:155], v[144:147], v[48:51]
    buffer_load_dwordx4 v[152:155], v2, s[32:35], s37 offen
    s_nop 7
    s_nop 1
    v_lshlrev_b32 v8, 16, v4
    v_and_b32 v9, 0xffff0000, v4
    v_lshlrev_b32 v10, 16, v5
    v_and_b32 v11, 0xffff0000, v5
    v_lshlrev_b32 v12, 16, v6
    v_and_b32 v13, 0xffff0000, v6
    v_lshlrev_b32 v14, 16, v7
    v_and_b32 v15, 0xffff0000, v7
    v_mul_f32 v16, v20, v8
    v_mul_f32 v17, v21, v8
    v_mul_f32 v18, v22, v8
    v_mul_f32 v19, v23, v8
    v_fmac_f32 v16, v24, v9
    v_fmac_f32 v17, v25, v9
    v_fmac_f32 v18, v26, v9
    v_fmac_f32 v19, v27, v9
    v_fmac_f32 v16, v28, v10
    v_fmac_f32 v17, v29, v10
    v_fmac_f32 v18, v30, v10
    v_fmac_f32 v19, v31, v10
    v_fmac_f32 v16, v32, v11
    v_fmac_f32 v17, v33, v11
    v_fmac_f32 v18, v34, v11
    v_fmac_f32 v19, v35, v11
    v_fmac_f32 v16, v36, v12
    v_fmac_f32 v17, v37, v12
    v_fmac_f32 v18, v38, v12
    v_fmac_f32 v19, v39, v12
    v_fmac_f32 v16, v40, v13
    v_fmac_f32 v17, v41, v13
    v_fmac_f32 v18, v42, v13
    v_fmac_f32 v19, v43, v13
    v_fmac_f32 v16, v44, v14
    v_fmac_f32 v17, v45, v14
    v_fmac_f32 v18, v46, v14
    v_fmac_f32 v19, v47, v14
    v_fmac_f32 v16, v48, v15
    v_fmac_f32 v17, v49, v15
    v_fmac_f32 v18, v50, v15
    v_fmac_f32 v19, v51, v15
    v_mov_b32 v20, 0
    v_mov_b32 v21, 0
    v_mov_b32 v22, 0
    v_mov_b32 v23, 0
    v_mov_b32 v24, 0
    v_mov_b32 v25, 0
    v_mov_b32 v26, 0
    v_mov_b32 v27, 0
    v_mov_b32 v28, 0
    v_mov_b32 v29, 0
    v_mov_b32 v30, 0
    v_mov_b32 v31, 0
    v_mov_b32 v32, 0
    v_mov_b32 v33, 0
    v_mov_b32 v34, 0
    v_mov_b32 v35, 0
    v_mov_b32 v36, 0
    v_mov_b32 v37, 0
    v_mov_b32 v38, 0
    v_mov_b32 v39, 0
    v_mov_b32 v40, 0
    v_mov_b32 v41, 0
    v_mov_b32 v42, 0
    v_mov_b32 v43, 0
    v_mov_b32 v44, 0
    v_mov_b32 v45, 0
    v_mov_b32 v46, 0
    v_mov_b32 v47, 0
    v_mov_b32 v48, 0
    v_mov_b32 v49, 0
    v_mov_b32 v50, 0
    v_mov_b32 v51, 0
    v_add_f32_dpp v16, v16, v16 row_ror:8 row_mask:0xf bank_mask:0xf
    v_add_f32_dpp v17, v17, v17 row_ror:8 row_mask:0xf bank_mask:0xf
    v_add_f32_dpp v18, v18, v18 row_ror:8 row_mask:0xf bank_mask:0xf
    v_add_f32_dpp v19, v19, v19 row_ror:8 row_mask:0xf bank_mask:0xf
    v_add_f32_dpp v16, v16, v16 row_ror:4 row_mask:0xf bank_mask:0xf
    v_add_f32_dpp v17, v17, v17 row_ror:4 row_mask:0xf bank_mask:0xf
    v_add_f32_dpp v18, v18, v18 row_ror:4 row_mask:0xf bank_mask:0xf
    v_add_f32_dpp v19, v19, v19 row_ror:4 row_mask:0xf bank_mask:0xf
    v_add_f32_dpp v16, v16, v16 row_ror:2 row_mask:0xf bank_mask:0xf
    v_add_f32_dpp v17, v17, v17 row_ror:2 row_mask:0xf bank_mask:0xf
    v_add_f32_dpp v18, v18, v18 row_ror:2 row_mask:0xf bank_mask:0xf
    v_add_f32_dpp v19, v19, v19 row_ror:2 row_mask:0xf bank_mask:0xf
    v_add_f32_dpp v16, v16, v16 row_ror:1 row_mask:0xf bank_mask:0xf
    v_add_f32_dpp v17, v17, v17 row_ror:1 row_mask:0xf bank_mask:0xf
    v_add_f32_dpp v18, v18, v18 row_ror:1 row_mask:0xf bank_mask:0xf
    v_add_f32_dpp v19, v19, v19 row_ror:1 row_mask:0xf bank_mask:0xf
    v_lshrrev_b32 v8, 4, v0
    v_lshlrev_b32 v8, 4, v8
    s_lshl_b32 s58, s3, 6
    s_add_u32 s58, s58, 2048
    v_add_u32 v8, s58, v8
    v_and_b32 v9, 15, v0
    v_cmp_eq_u32 vcc, 0, v9
    s_and_saveexec_b64 s[44:45], vcc
    ds_write_b128 v8, v[16:19]
    s_mov_b64 exec, 1
    v_mov_b32 v9, 2368
    v_mov_b32 v10, 1
    s_waitcnt lgkmcnt(0)
    ds_add_u32 v9, v10
    s_mov_b64 exec, -1
    s_nop 1
    s_waitcnt vmcnt(5)
    buffer_load_dwordx4 v[72:75], v1, s[24:27], s36 offen offset:1280 nt
    buffer_load_dwordx4 v[76:79], v1, s[24:27], s36 offen offset:1536 nt
    v_mfma_f32_16x16x32_bf16 v[20:23], v[148:151], v[84:87], v[20:23]
    s_waitcnt vmcnt(6)
    v_perm_b32 v116, v56, v52, s40
    v_perm_b32 v120, v56, v52, s41
    v_perm_b32 v124, v57, v53, s40
    v_perm_b32 v128, v57, v53, s41
    v_perm_b32 v132, v58, v54, s40
    v_perm_b32 v136, v58, v54, s41
    v_perm_b32 v140, v59, v55, s40
    v_perm_b32 v144, v59, v55, s41
    v_mfma_f32_16x16x32_bf16 v[24:27], v[148:151], v[88:91], v[24:27]
    s_waitcnt vmcnt(5)
    buffer_load_dwordx4 v[80:83], v1, s[24:27], s36 offen offset:1792 nt
    v_mfma_f32_16x16x32_bf16 v[28:31], v[148:151], v[92:95], v[28:31]
    s_add_u32 s36, s36, 32768
    s_lshr_b32 s37, s36, 7
    s_waitcnt vmcnt(5)
    buffer_load_dwordx4 v[52:55], v1, s[24:27], s36 offen offset:0 nt
    v_perm_b32 v117, v64, v60, s40
    v_perm_b32 v121, v64, v60, s41
    v_perm_b32 v125, v65, v61, s40
    v_perm_b32 v129, v65, v61, s41
    v_perm_b32 v133, v66, v62, s40
    v_perm_b32 v137, v66, v62, s41
    v_perm_b32 v141, v67, v63, s40
    v_perm_b32 v145, v67, v63, s41
    v_mfma_f32_16x16x32_bf16 v[32:35], v[148:151], v[96:99], v[32:35]
    s_waitcnt vmcnt(5)
    buffer_load_dwordx4 v[56:59], v1, s[24:27], s36 offen offset:256 nt
    buffer_load_dwordx4 v[60:63], v1, s[24:27], s36 offen offset:512 nt
    v_mfma_f32_16x16x32_bf16 v[36:39], v[148:151], v[100:103], v[36:39]
    s_waitcnt vmcnt(5)
    v_perm_b32 v118, v72, v68, s40
    v_perm_b32 v122, v72, v68, s41
    v_perm_b32 v126, v73, v69, s40
    v_perm_b32 v130, v73, v69, s41
    v_perm_b32 v134, v74, v70, s40
    v_perm_b32 v138, v74, v70, s41
    v_perm_b32 v142, v75, v71, s40
    v_perm_b32 v146, v75, v71, s41
    v_mfma_f32_16x16x32_bf16 v[40:43], v[148:151], v[104:107], v[40:43]
    s_waitcnt vmcnt(4)
    buffer_load_dwordx4 v[64:67], v1, s[24:27], s36 offen offset:768 nt
    v_mfma_f32_16x16x32_bf16 v[44:47], v[148:151], v[108:111], v[44:47]
    s_waitcnt vmcnt(4)
    buffer_load_dwordx4 v[68:71], v1, s[24:27], s36 offen offset:1024 nt
    v_perm_b32 v119, v80, v76, s40
    v_perm_b32 v123, v80, v76, s41
    v_perm_b32 v127, v81, v77, s40
    v_perm_b32 v131, v81, v77, s41
    v_perm_b32 v135, v82, v78, s40
    v_perm_b32 v139, v82, v78, s41
    v_perm_b32 v143, v83, v79, s40
    v_perm_b32 v147, v83, v79, s41
    v_mfma_f32_16x16x32_bf16 v[48:51], v[148:151], v[112:115], v[48:51]
    buffer_load_dwordx4 v[148:151], v2, s[32:35], s37 offen
    s_mov_b32 s38, 26
L_v_loop_a:
    s_cmp_lg_u32 s38, 4
    s_cbranch_scc1 L_v_nosig_a
    v_mov_b32 v158, 1
    s_mov_b64 exec, 1
    ds_max_u32 v159, v158
    s_mov_b64 exec, -1
L_v_nosig_a:
    s_waitcnt vmcnt(5)
    buffer_load_dwordx4 v[72:75], v1, s[24:27], s36 offen offset:1280 nt
    buffer_load_dwordx4 v[76:79], v1, s[24:27], s36 offen offset:1536 nt
    v_mfma_f32_16x16x32_bf16 v[20:23], v[152:155], v[116:119], v[20:23]
    s_waitcnt vmcnt(6)
    v_perm_b32 v84, v56, v52, s40
    v_perm_b32 v88, v56, v52, s41
    v_perm_b32 v92, v57, v53, s40
    v_perm_b32 v96, v57, v53, s41
    v_perm_b32 v100, v58, v54, s40
    v_perm_b32 v104, v58, v54, s41
    v_perm_b32 v108, v59, v55, s40
    v_perm_b32 v112, v59, v55, s41
    v_mfma_f32_16x16x32_bf16 v[24:27], v[152:155], v[120:123], v[24:27]
    s_waitcnt vmcnt(5)
    buffer_load_dwordx4 v[80:83], v1, s[24:27], s36 offen offset:1792 nt
    v_mfma_f32_16x16x32_bf16 v[28:31], v[152:155], v[124:127], v[28:31]
    s_add_u32 s36, s36, 32768
    s_lshr_b32 s37, s36, 7
    s_waitcnt vmcnt(5)
    buffer_load_dwordx4 v[52:55], v1, s[24:27], s36 offen offset:0 nt
    v_perm_b32 v85, v64, v60, s40
    v_perm_b32 v89, v64, v60, s41
    v_perm_b32 v93, v65, v61, s40
    v_perm_b32 v97, v65, v61, s41
    v_perm_b32 v101, v66, v62, s40
    v_perm_b32 v105, v66, v62, s41
    v_perm_b32 v109, v67, v63, s40
    v_perm_b32 v113, v67, v63, s41
    v_mfma_f32_16x16x32_bf16 v[32:35], v[152:155], v[128:131], v[32:35]
    s_waitcnt vmcnt(5)
    buffer_load_dwordx4 v[56:59], v1, s[24:27], s36 offen offset:256 nt
    buffer_load_dwordx4 v[60:63], v1, s[24:27], s36 offen offset:512 nt
    v_mfma_f32_16x16x32_bf16 v[36:39], v[152:155], v[132:135], v[36:39]
    s_waitcnt vmcnt(5)
    v_perm_b32 v86, v72, v68, s40
    v_perm_b32 v90, v72, v68, s41
    v_perm_b32 v94, v73, v69, s40
    v_perm_b32 v98, v73, v69, s41
    v_perm_b32 v102, v74, v70, s40
    v_perm_b32 v106, v74, v70, s41
    v_perm_b32 v110, v75, v71, s40
    v_perm_b32 v114, v75, v71, s41
    v_mfma_f32_16x16x32_bf16 v[40:43], v[152:155], v[136:139], v[40:43]
    s_waitcnt vmcnt(4)
    buffer_load_dwordx4 v[64:67], v1, s[24:27], s36 offen offset:768 nt
    v_mfma_f32_16x16x32_bf16 v[44:47], v[152:155], v[140:143], v[44:47]
    s_waitcnt vmcnt(4)
    buffer_load_dwordx4 v[68:71], v1, s[24:27], s36 offen offset:1024 nt
    v_perm_b32 v87, v80, v76, s40
    v_perm_b32 v91, v80, v76, s41
    v_perm_b32 v95, v81, v77, s40
    v_perm_b32 v99, v81, v77, s41
    v_perm_b32 v103, v82, v78, s40
    v_perm_b32 v107, v82, v78, s41
    v_perm_b32 v111, v83, v79, s40
    v_perm_b32 v115, v83, v79, s41
    v_mfma_f32_16x16x32_bf16 v[48:51], v[152:155], v[144:147], v[48:51]
    buffer_load_dwordx4 v[152:155], v2, s[32:35], s37 offen
    s_waitcnt vmcnt(5)
    buffer_load_dwordx4 v[72:75], v1, s[24:27], s36 offen offset:1280 nt
    buffer_load_dwordx4 v[76:79], v1, s[24:27], s36 offen offset:1536 nt
    v_mfma_f32_16x16x32_bf16 v[20:23], v[148:151], v[84:87], v[20:23]
    s_waitcnt vmcnt(6)
    v_perm_b32 v116, v56, v52, s40
    v_perm_b32 v120, v56, v52, s41
    v_perm_b32 v124, v57, v53, s40
    v_perm_b32 v128, v57, v53, s41
    v_perm_b32 v132, v58, v54, s40
    v_perm_b32 v136, v58, v54, s41
    v_perm_b32 v140, v59, v55, s40
    v_perm_b32 v144, v59, v55, s41
    v_mfma_f32_16x16x32_bf16 v[24:27], v[148:151], v[88:91], v[24:27]
    s_waitcnt vmcnt(5)
    buffer_load_dwordx4 v[80:83], v1, s[24:27], s36 offen offset:1792 nt
    v_mfma_f32_16x16x32_bf16 v[28:31], v[148:151], v[92:95], v[28:31]
    s_add_u32 s36, s36, 32768
    s_lshr_b32 s37, s36, 7
    s_waitcnt vmcnt(5)
    buffer_load_dwordx4 v[52:55], v1, s[24:27], s36 offen offset:0 nt
    v_perm_b32 v117, v64, v60, s40
    v_perm_b32 v121, v64, v60, s41
    v_perm_b32 v125, v65, v61, s40
    v_perm_b32 v129, v65, v61, s41
    v_perm_b32 v133, v66, v62, s40
    v_perm_b32 v137, v66, v62, s41
    v_perm_b32 v141, v67, v63, s40
    v_perm_b32 v145, v67, v63, s41
    v_mfma_f32_16x16x32_bf16 v[32:35], v[148:151], v[96:99], v[32:35]
    s_waitcnt vmcnt(5)
    buffer_load_dwordx4 v[56:59], v1, s[24:27], s36 offen offset:256 nt
    buffer_load_dwordx4 v[60:63], v1, s[24:27], s36 offen offset:512 nt
    v_mfma_f32_16x16x32_bf16 v[36:39], v[148:151], v[100:103], v[36:39]
    s_waitcnt vmcnt(5)
    v_perm_b32 v118, v72, v68, s40
    v_perm_b32 v122, v72, v68, s41
    v_perm_b32 v126, v73, v69, s40
    v_perm_b32 v130, v73, v69, s41
    v_perm_b32 v134, v74, v70, s40
    v_perm_b32 v138, v74, v70, s41
    v_perm_b32 v142, v75, v71, s40
    v_perm_b32 v146, v75, v71, s41
    v_mfma_f32_16x16x32_bf16 v[40:43], v[148:151], v[104:107], v[40:43]
    s_waitcnt vmcnt(4)
    buffer_load_dwordx4 v[64:67], v1, s[24:27], s36 offen offset:768 nt
    v_mfma_f32_16x16x32_bf16 v[44:47], v[148:151], v[108:111], v[44:47]
    s_waitcnt vmcnt(4)
    buffer_load_dwordx4 v[68:71], v1, s[24:27], s36 offen offset:1024 nt
    v_perm_b32 v119, v80, v76, s40
    v_perm_b32 v123, v80, v76, s41
    v_perm_b32 v127, v81, v77, s40
    v_perm_b32 v131, v81, v77, s41
    v_perm_b32 v135, v82, v78, s40
    v_perm_b32 v139, v82, v78, s41
    v_perm_b32 v143, v83, v79, s40
    v_perm_b32 v147, v83, v79, s41
    v_mfma_f32_16x16x32_bf16 v[48:51], v[148:151], v[112:115], v[48:51]
    buffer_load_dwordx4 v[148:151], v2, s[32:35], s37 offen
    s_sub_u32 s38, s38, 1
    s_cmp_lg_u32 s38, 0
    s_cbranch_scc1 L_v_loop_a
    v_mov_b32 v158, 2
    s_mov_b64 exec, 1
    ds_max_u32 v159, v158
    s_mov_b64 exec, -1
    s_waitcnt vmcnt(5)
    buffer_load_dwordx4 v[72:75], v1, s[24:27], s36 offen offset:1280 nt
    buffer_load_dwordx4 v[76:79], v1, s[24:27], s36 offen offset:1536 nt
    v_mfma_f32_16x16x32_bf16 v[20:23], v[152:155], v[116:119], v[20:23]
    s_waitcnt vmcnt(6)
    v_perm_b32 v84, v56, v52, s40
    v_perm_b32 v88, v56, v52, s41
    v_perm_b32 v92, v57, v53, s40
    v_perm_b32 v96, v57, v53, s41
    v_perm_b32 v100, v58, v54, s40
    v_perm_b32 v104, v58, v54, s41
    v_perm_b32 v108, v59, v55, s40
    v_perm_b32 v112, v59, v55, s41
    v_mfma_f32_16x16x32_bf16 v[24:27], v[152:155], v[120:123], v[24:27]
    s_waitcnt vmcnt(5)
    buffer_load_dwordx4 v[80:83], v1, s[24:27], s36 offen offset:1792 nt
    v_mfma_f32_16x16x32_bf16 v[28:31], v[152:155], v[124:127], v[28:31]
    s_add_u32 s36, s36, 32768
    s_lshr_b32 s37, s36, 7
    s_waitcnt vmcnt(5)
    buffer_load_dwordx4 v[52:55], v1, s[24:27], s36 offen offset:0 nt
    v_perm_b32 v85, v64, v60, s40
    v_perm_b32 v89, v64, v60, s41
    v_perm_b32 v93, v65, v61, s40
    v_perm_b32 v97, v65, v61, s41
    v_perm_b32 v101, v66, v62, s40
    v_perm_b32 v105, v66, v62, s41
    v_perm_b32 v109, v67, v63, s40
    v_perm_b32 v113, v67, v63, s41
    v_mfma_f32_16x16x32_bf16 v[32:35], v[152:155], v[128:131], v[32:35]
    s_waitcnt vmcnt(5)
    buffer_load_dwordx4 v[56:59], v1, s[24:27], s36 offen offset:256 nt
    buffer_load_dwordx4 v[60:63], v1, s[24:27], s36 offen offset:512 nt
    v_mfma_f32_16x16x32_bf16 v[36:39], v[152:155], v[132:135], v[36:39]
    s_waitcnt vmcnt(5)
    v_perm_b32 v86, v72, v68, s40
    v_perm_b32 v90, v72, v68, s41
    v_perm_b32 v94, v73, v69, s40
    v_perm_b32 v98, v73, v69, s41
    v_perm_b32 v102, v74, v70, s40
    v_perm_b32 v106, v74, v70, s41
    v_perm_b32 v110, v75, v71, s40
    v_perm_b32 v114, v75, v71, s41
    v_mfma_f32_16x16x32_bf16 v[40:43], v[152:155], v[136:139], v[40:43]
    s_waitcnt vmcnt(4)
    buffer_load_dwordx4 v[64:67], v1, s[24:27], s36 offen offset:768 nt
    v_mfma_f32_16x16x32_bf16 v[44:47], v[152:155], v[140:143], v[44:47]
    s_waitcnt vmcnt(4)
    buffer_load_dwordx4 v[68:71], v1, s[24:27], s36 offen offset:1024 nt
    v_perm_b32 v87, v80, v76, s40
    v_perm_b32 v91, v80, v76, s41
    v_perm_b32 v95, v81, v77, s40
    v_perm_b32 v99, v81, v77, s41
    v_perm_b32 v103, v82, v78, s40
    v_perm_b32 v107, v82, v78, s41
    v_perm_b32 v111, v83, v79, s40
    v_perm_b32 v115, v83, v79, s41
    v_mfma_f32_16x16x32_bf16 v[48:51], v[152:155], v[144:147], v[48:51]
    buffer_load_dwordx4 v[152:155], v2, s[32:35], s37 offen
    v_mov_b32 v9, 2372
L_pwait_a:
    ds_read_b32 v10, v9
    s_waitcnt lgkmcnt(0)
    v_readfirstlane_b32 s58, v10
    s_nop 3
    s_cmp_eq_u32 s58, 0
    s_cbranch_scc1 L_pwait_a
    v_lshrrev_b32 v8, 4, v0
    v_lshlrev_b32 v9, 4, v8
    ds_read_b128 v[12:15], v9 offset:2304
    v_and_b32 v10, 1, v8
    v_lshlrev_b32 v10, 1, v10
    v_lshrrev_b32 v11, 1, v8
    v_or_b32 v10, v10, v11
    v_and_b32 v11, 15, v0
    v_lshl_add_u32 v10, v11, 3, v10
    v_lshlrev_b32 v10, 2, v10
    s_lshl_b32 s58, s3, 9
    v_add_u32 v10, s58, v10
    s_waitcnt lgkmcnt(0)
    ds_read_b32 v156, v157
    s_add_u32 s53, s53, 1
    v_mov_b32 v158, s53
    s_mov_b64 exec, 1
    ds_max_u32 v159, v158
    s_mov_b64 exec, -1
    s_waitcnt vmcnt(5)
    buffer_load_dwordx4 v[72:75], v1, s[24:27], s36 offen offset:1280 nt
    buffer_load_dwordx4 v[76:79], v1, s[24:27], s36 offen offset:1536 nt
    v_mfma_f32_16x16x32_bf16 v[20:23], v[148:151], v[84:87], v[20:23]
    s_waitcnt vmcnt(6)
    v_perm_b32 v116, v56, v52, s40
    v_perm_b32 v120, v56, v52, s41
    v_perm_b32 v124, v57, v53, s40
    v_perm_b32 v128, v57, v53, s41
    v_perm_b32 v132, v58, v54, s40
    v_perm_b32 v136, v58, v54, s41
    v_perm_b32 v140, v59, v55, s40
    v_perm_b32 v144, v59, v55, s41
    v_mfma_f32_16x16x32_bf16 v[24:27], v[148:151], v[88:91], v[24:27]
    s_waitcnt vmcnt(5)
    buffer_load_dwordx4 v[80:83], v1, s[24:27], s36 offen offset:1792 nt
    v_mfma_f32_16x16x32_bf16 v[28:31], v[148:151], v[92:95], v[28:31]
    s_waitcnt lgkmcnt(0)
    v_readfirstlane_b32 s55, v156
    s_nop 3
    s_cmp_lg_u32 s55, -1
    s_cbranch_scc1 L_got1
L_spin1:
    ds_read_b32 v156, v157
    s_waitcnt lgkmcnt(0)
    v_readfirstlane_b32 s55, v156
    s_nop 3
    s_cmp_eq_u32 s55, -1
    s_cbranch_scc1 L_spin1
L_got1:
    s_add_u32 s36, s55, s56
    s_cmp_eq_u32 s55, 1073741824
    s_cselect_b32 s54, 1, 0
    s_lshr_b32 s37, s36, 7
    s_waitcnt vmcnt(5)
    buffer_load_dwordx4 v[52:55], v1, s[24:27], s36 offen offset:0 nt
    v_add_u32 v157, 4, v157
    v_perm_b32 v117, v64, v60, s40
    v_perm_b32 v121, v64, v60, s41
    v_perm_b32 v125, v65, v61, s40
    v_perm_b32 v129, v65, v61, s41
    v_perm_b32 v133, v66, v62, s40
    v_perm_b32 v137, v66, v62, s41
    v_perm_b32 v141, v67, v63, s40
    v_perm_b32 v145, v67, v63, s41
    v_mfma_f32_16x16x32_bf16 v[32:35], v[148:151], v[96:99], v[32:35]
    s_waitcnt vmcnt(5)
    buffer_load_dwordx4 v[56:59], v1, s[24:27], s36 offen offset:256 nt
    buffer_load_dwordx4 v[60:63], v1, s[24:27], s36 offen offset:512 nt
    v_mfma_f32_16x16x32_bf16 v[36:39], v[148:151], v[100:103], v[36:39]
    s_sub_u32 s59, s53, 2
    v_mov_b32 v158, s59
    s_mov_b64 exec, 1
    ds_max_u32 v159, v158 offset:4
    s_mov_b64 exec, -1
    s_waitcnt vmcnt(5)
    v_perm_b32 v118, v72, v68, s40
    v_perm_b32 v122, v72, v68, s41
    v_perm_b32 v126, v73, v69, s40
    v_perm_b32 v130, v73, v69, s41
    v_perm_b32 v134, v74, v70, s40
    v_perm_b32 v138, v74, v70, s41
    v_perm_b32 v142, v75, v71, s40
    v_perm_b32 v146, v75, v71, s41
    v_mfma_f32_16x16x32_bf16 v[40:43], v[148:151], v[104:107], v[40:43]
    s_waitcnt vmcnt(4)
    buffer_load_dwordx4 v[64:67], v1, s[24:27], s36 offen offset:768 nt
    v_mfma_f32_16x16x32_bf16 v[44:47], v[148:151], v[108:111], v[44:47]
    s_waitcnt vmcnt(4)
    buffer_load_dwordx4 v[68:71], v1, s[24:27], s36 offen offset:1024 nt
    v_perm_b32 v119, v80, v76, s40
    v_perm_b32 v123, v80, v76, s41
    v_perm_b32 v127, v81, v77, s40
    v_perm_b32 v131, v81, v77, s41
    v_perm_b32 v135, v82, v78, s40
    v_perm_b32 v139, v82, v78, s41
    v_perm_b32 v143, v83, v79, s40
    v_perm_b32 v147, v83, v79, s41
    v_mfma_f32_16x16x32_bf16 v[48:51], v[148:151], v[112:115], v[48:51]
    buffer_load_dwordx4 v[148:151], v2, s[32:35], s37 offen
    s_cmp_lg_u32 s54, 0
    s_cbranch_scc1 L_exit1_a
L_pool_a:
    ds_read_b32 v156, v157
    s_add_u32 s53, s53, 1
    v_mov_b32 v158, s53
    s_mov_b64 exec, 1
    ds_max_u32 v159, v158
    s_mov_b64 exec, -1
    s_waitcnt vmcnt(5)
    buffer_load_dwordx4 v[72:75], v1, s[24:27], s36 offen offset:1280 nt
    buffer_load_dwordx4 v[76:79], v1, s[24:27], s36 offen offset:1536 nt
    v_mfma_f32_16x16x32_bf16 v[20:23], v[152:155], v[116:119], v[20:23]
    s_waitcnt vmcnt(6)
    v_perm_b32 v84, v56, v52, s40
    v_perm_b32 v88, v56, v52, s41
    v_perm_b32 v92, v57, v53, s40
    v_perm_b32 v96, v57, v53, s41
    v_perm_b32 v100, v58, v54, s40
    v_perm_b32 v104, v58, v54, s41
    v_perm_b32 v108, v59, v55, s40
    v_perm_b32 v112, v59, v55, s41
    v_mfma_f32_16x16x32_bf16 v[24:27], v[152:155], v[120:123], v[24:27]
    s_waitcnt vmcnt(5)
    buffer_load_dwordx4 v[80:83], v1, s[24:27], s36 offen offset:1792 nt
    v_mfma_f32_16x16x32_bf16 v[28:31], v[152:155], v[124:127], v[28:31]
    s_waitcnt lgkmcnt(0)
    v_readfirstlane_b32 s55, v156
    s_nop 3
    s_cmp_lg_u32 s55, -1
    s_cbranch_scc1 L_got2
L_spin2:
    ds_read_b32 v156, v157
    s_waitcnt lgkmcnt(0)
    v_readfirstlane_b32 s55, v156
    s_nop 3
    s_cmp_eq_u32 s55, -1
    s_cbranch_scc1 L_spin2
L_got2:
    s_add_u32 s36, s55, s56
    s_cmp_eq_u32 s55, 1073741824
    s_cselect_b32 s54, 1, 0
    s_lshr_b32 s37, s36, 7
    s_waitcnt vmcnt(5)
    buffer_load_dwordx4 v[52:55], v1, s[24:27], s36 offen offset:0 nt
    v_add_u32 v157, 4, v157
    v_perm_b32 v85, v64, v60, s40
    v_perm_b32 v89, v64, v60, s41
    v_perm_b32 v93, v65, v61, s40
    v_perm_b32 v97, v65, v61, s41
    v_perm_b32 v101, v66, v62, s40
    v_perm_b32 v105, v66, v62, s41
    v_perm_b32 v109, v67, v63, s40
    v_perm_b32 v113, v67, v63, s41
    v_mfma_f32_16x16x32_bf16 v[32:35], v[152:155], v[128:131], v[32:35]
    s_waitcnt vmcnt(5)
    buffer_load_dwordx4 v[56:59], v1, s[24:27], s36 offen offset:256 nt
    buffer_load_dwordx4 v[60:63], v1, s[24:27], s36 offen offset:512 nt
    v_mfma_f32_16x16x32_bf16 v[36:39], v[152:155], v[132:135], v[36:39]
    s_sub_u32 s59, s53, 2
    v_mov_b32 v158, s59
    s_mov_b64 exec, 1
    ds_max_u32 v159, v158 offset:4
    s_mov_b64 exec, -1
    s_waitcnt vmcnt(5)
    v_perm_b32 v86, v72, v68, s40
    v_perm_b32 v90, v72, v68, s41
    v_perm_b32 v94, v73, v69, s40
    v_perm_b32 v98, v73, v69, s41
    v_perm_b32 v102, v74, v70, s40
    v_perm_b32 v106, v74, v70, s41
    v_perm_b32 v110, v75, v71, s40
    v_perm_b32 v114, v75, v71, s41
    v_mfma_f32_16x16x32_bf16 v[40:43], v[152:155], v[136:139], v[40:43]
    s_waitcnt vmcnt(4)
    buffer_load_dwordx4 v[64:67], v1, s[24:27], s36 offen offset:768 nt
    v_mfma_f32_16x16x32_bf16 v[44:47], v[152:155], v[140:143], v[44:47]
    s_waitcnt vmcnt(4)
    buffer_load_dwordx4 v[68:71], v1, s[24:27], s36 offen offset:1024 nt
    v_perm_b32 v87, v80, v76, s40
    v_perm_b32 v91, v80, v76, s41
    v_perm_b32 v95, v81, v77, s40
    v_perm_b32 v99, v81, v77, s41
    v_perm_b32 v103, v82, v78, s40
    v_perm_b32 v107, v82, v78, s41
    v_perm_b32 v111, v83, v79, s40
    v_perm_b32 v115, v83, v79, s41
    v_mfma_f32_16x16x32_bf16 v[48:51], v[152:155], v[144:147], v[48:51]
    buffer_load_dwordx4 v[152:155], v2, s[32:35], s37 offen
    s_add_u32 s57, s57, 1
    s_cmp_lg_u32 s54, 0
    s_cbranch_scc1 L_exit0_a
    ds_read_b32 v156, v157
    s_add_u32 s53, s53, 1
    v_mov_b32 v158, s53
    s_mov_b64 exec, 1
    ds_max_u32 v159, v158
    s_mov_b64 exec, -1
    s_waitcnt vmcnt(5)
    buffer_load_dwordx4 v[72:75], v1, s[24:27], s36 offen offset:1280 nt
    buffer_load_dwordx4 v[76:79], v1, s[24:27], s36 offen offset:1536 nt
    v_mfma_f32_16x16x32_bf16 v[20:23], v[148:151], v[84:87], v[20:23]
    s_waitcnt vmcnt(6)
    v_perm_b32 v116, v56, v52, s40
    v_perm_b32 v120, v56, v52, s41
    v_perm_b32 v124, v57, v53, s40
    v_perm_b32 v128, v57, v53, s41
    v_perm_b32 v132, v58, v54, s40
    v_perm_b32 v136, v58, v54, s41
    v_perm_b32 v140, v59, v55, s40
    v_perm_b32 v144, v59, v55, s41
    v_mfma_f32_16x16x32_bf16 v[24:27], v[148:151], v[88:91], v[24:27]
    s_waitcnt vmcnt(5)
    buffer_load_dwordx4 v[80:83], v1, s[24:27], s36 offen offset:1792 nt
    v_mfma_f32_16x16x32_bf16 v[28:31], v[148:151], v[92:95], v[28:31]
    s_waitcnt lgkmcnt(0)
    v_readfirstlane_b32 s55, v156
    s_nop 3
    s_cmp_lg_u32 s55, -1
    s_cbranch_scc1 L_got3
L_spin3:
    ds_read_b32 v156, v157
    s_waitcnt lgkmcnt(0)
    v_readfirstlane_b32 s55, v156
    s_nop 3
    s_cmp_eq_u32 s55, -1
    s_cbranch_scc1 L_spin3
L_got3:
    s_add_u32 s36, s55, s56
    s_cmp_eq_u32 s55, 1073741824
    s_cselect_b32 s54, 1, 0
    s_lshr_b32 s37, s36, 7
    s_waitcnt vmcnt(5)
    buffer_load_dwordx4 v[52:55], v1, s[24:27], s36 offen offset:0 nt
    v_add_u32 v157, 4, v157
    v_perm_b32 v117, v64, v60, s40
    v_perm_b32 v121, v64, v60, s41
    v_perm_b32 v125, v65, v61, s40
    v_perm_b32 v129, v65, v61, s41
    v_perm_b32 v133, v66, v62, s40
    v_perm_b32 v137, v66, v62, s41
    v_perm_b32 v141, v67, v63, s40
    v_perm_b32 v145, v67, v63, s41
    v_mfma_f32_16x16x32_bf16 v[32:35], v[148:151], v[96:99], v[32:35]
    s_waitcnt vmcnt(5)
    buffer_load_dwordx4 v[56:59], v1, s[24:27], s36 offen offset:256 nt
    buffer_load_dwordx4 v[60:63], v1, s[24:27], s36 offen offset:512 nt
    v_mfma_f32_16x16x32_bf16 v[36:39], v[148:151], v[100:103], v[36:39]
    s_sub_u32 s59, s53, 2
    v_mov_b32 v158, s59
    s_mov_b64 exec, 1
    ds_max_u32 v159, v158 offset:4
    s_mov_b64 exec, -1
    s_waitcnt vmcnt(5)
    v_perm_b32 v118, v72, v68, s40
    v_perm_b32 v122, v72, v68, s41
    v_perm_b32 v126, v73, v69, s40
    v_perm_b32 v130, v73, v69, s41
    v_perm_b32 v134, v74, v70, s40
    v_perm_b32 v138, v74, v70, s41
    v_perm_b32 v142, v75, v71, s40
    v_perm_b32 v146, v75, v71, s41
    v_mfma_f32_16x16x32_bf16 v[40:43], v[148:151], v[104:107], v[40:43]
    s_waitcnt vmcnt(4)
    buffer_load_dwordx4 v[64:67], v1, s[24:27], s36 offen offset:768 nt
    v_mfma_f32_16x16x32_bf16 v[44:47], v[148:151], v[108:111], v[44:47]
    s_waitcnt vmcnt(4)
    buffer_load_dwordx4 v[68:71], v1, s[24:27], s36 offen offset:1024 nt
    v_perm_b32 v119, v80, v76, s40
    v_perm_b32 v123, v80, v76, s41
    v_perm_b32 v127, v81, v77, s40
    v_perm_b32 v131, v81, v77, s41
    v_perm_b32 v135, v82, v78, s40
    v_perm_b32 v139, v82, v78, s41
    v_perm_b32 v143, v83, v79, s40
    v_perm_b32 v147, v83, v79, s41
    v_mfma_f32_16x16x32_bf16 v[48:51], v[148:151], v[112:115], v[48:51]
    buffer_load_dwordx4 v[148:151], v2, s[32:35], s37 offen
    s_add_u32 s57, s57, 1
    s_cmp_eq_u32 s54, 0
    s_cbranch_scc1 L_pool_a
L_exit1_a:
    v_mfma_f32_16x16x32_bf16 v[20:23], v[152:155], v[116:119], v[20:23]
    v_mfma_f32_16x16x32_bf16 v[24:27], v[152:155], v[120:123], v[24:27]
    v_mfma_f32_16x16x32_bf16 v[28:31], v[152:155], v[124:127], v[28:31]
    v_mfma_f32_16x16x32_bf16 v[32:35], v[152:155], v[128:131], v[32:35]
    v_mfma_f32_16x16x32_bf16 v[36:39], v[152:155], v[132:135], v[36:39]
    v_mfma_f32_16x16x32_bf16 v[40:43], v[152:155], v[136:139], v[40:43]
    v_mfma_f32_16x16x32_bf16 v[44:47], v[152:155], v[140:143], v[44:47]
    v_mfma_f32_16x16x32_bf16 v[48:51], v[152:155], v[144:147], v[48:51]
    s_branch L_vdone
L_exit0_a:
    v_mfma_f32_16x16x32_bf16 v[20:23], v[148:151], v[84:87], v[20:23]
    v_mfma_f32_16x16x32_bf16 v[24:27], v[148:151], v[88:91], v[24:27]
    v_mfma_f32_16x16x32_bf16 v[28:31], v[148:151], v[92:95], v[28:31]
    v_mfma_f32_16x16x32_bf16 v[32:35], v[148:151], v[96:99], v[32:35]
    v_mfma_f32_16x16x32_bf16 v[36:39], v[148:151], v[100:103], v[36:39]
    v_mfma_f32_16x16x32_bf16 v[40:43], v[148:151], v[104:107], v[40:43]
    v_mfma_f32_16x16x32_bf16 v[44:47], v[148:151], v[108:111], v[44:47]
    v_mfma_f32_16x16x32_bf16 v[48:51], v[148:151], v[112:115], v[48:51]
    s_branch L_vdone
L_vdone:
    s_waitcnt vmcnt(0)
    s_nop 7
    v_mul_f32 v52, v20, v12
    v_mul_f32 v53, v24, v12
    v_mul_f32 v54, v28, v12
    v_mul_f32 v55, v32, v12
    v_mul_f32 v56, v36, v12
    v_mul_f32 v57, v40, v12
    v_mul_f32 v58, v44, v12
    v_mul_f32 v59, v48, v12
    v_fmac_f32 v52, v21, v13
    v_fmac_f32 v53, v25, v13
    v_fmac_f32 v54, v29, v13
    v_fmac_f32 v55, v33, v13
    v_fmac_f32 v56, v37, v13
    v_fmac_f32 v57, v41, v13
    v_fmac_f32 v58, v45, v13
    v_fmac_f32 v59, v49, v13
    v_fmac_f32 v52, v22, v14
    v_fmac_f32 v53, v26, v14
    v_fmac_f32 v54, v30, v14
    v_fmac_f32 v55, v34, v14
    v_fmac_f32 v56, v38, v14
    v_fmac_f32 v57, v42, v14
    v_fmac_f32 v58, v46, v14
    v_fmac_f32 v59, v50, v14
    v_fmac_f32 v52, v23, v15
    v_fmac_f32 v53, v27, v15
    v_fmac_f32 v54, v31, v15
    v_fmac_f32 v55, v35, v15
    v_fmac_f32 v56, v39, v15
    v_fmac_f32 v57, v43, v15
    v_fmac_f32 v58, v47, v15
    v_fmac_f32 v59, v51, v15
    s_nop 1
    v_permlane32_swap_b32 v52, v53
    v_permlane32_swap_b32 v54, v55
    v_permlane32_swap_b32 v56, v57
    v_permlane32_swap_b32 v58, v59
    s_nop 1
    v_add_f32 v52, v52, v53
    v_add_f32 v54, v54, v55
    v_add_f32 v56, v56, v57
    v_add_f32 v58, v58, v59
    s_nop 1
    v_permlane16_swap_b32 v52, v54
    v_permlane16_swap_b32 v56, v58
    s_nop 1
    v_add_f32 v52, v52, v54
    v_add_f32 v56, v56, v58
    ds_write_b32 v10, v52 offset:0
    ds_write_b32 v10, v56 offset:16
    s_waitcnt lgkmcnt(0)
    s_barrier
    s_endpgm
L_ctrl:
    v_lshlrev_b32 v1, 2, v0
    v_mov_b32 v2, -1
    ds_write_b32 v1, v2 offset:2432
    ds_write_b32 v1, v2 offset:2688
    ds_write_b32 v1, v2 offset:2944
    ds_write_b32 v1, v2 offset:3200
    ds_write_b32 v1, v2 offset:3456
    ds_write_b32 v1, v2 offset:3712
    ds_write_b32 v1, v2 offset:3968
    ds_write_b32 v1, v2 offset:4224
    v_mov_b32 v2, 0
    s_mov_b64 exec, 0xf
    ds_write_b32 v1, v2 offset:2368
    s_mov_b64 exec, -1
    s_waitcnt lgkmcnt(0)
    s_barrier
    v_lshlrev_b32 v11, 3, v0
    v_mov_b32 v12, -1
    v_mov_b32 v13, -1
    s_lshl_b32 s58, s2, 9
    s_add_u32 s58, s58, 65536
    s_waitcnt lgkmcnt(0)
    s_add_u32 s48, s18, s58
    s_addc_u32 s49, s19, 0
    s_and_b32 s49, s49, 0xffff
    s_mov_b32 s50, 512
    s_mov_b32 s51, 0x20000
    buffer_store_dwordx2 v[12:13], v11, s[48:51], 0 offen sc1
    s_mul_i32 s58, s39, 4096
    s_add_u32 s58, s58, 262144
    v_mov_b32 v4, s58
    s_cmp_lg_u32 s42, 0
    s_cbranch_scc1 L_c_noinit
    s_mov_b64 exec, 1
    v_mov_b32 v12, 0
    v_mov_b32 v13, 0
    global_store_dwordx2 v4, v[12:13], s[18:19] sc1
    s_mov_b64 exec, -1
L_c_noinit:
    v_mov_b32 v3, 2368
L_c_wk:
    s_sleep 8
    ds_read_b32 v5, v3
    s_waitcnt lgkmcnt(0)
    v_readfirstlane_b32 s58, v5
    s_nop 3
    s_cmp_lt_u32 s58, 4
    s_cbranch_scc1 L_c_wk
    ds_read_b32 v8, v1 offset:2048
    ds_read_b32 v9, v1 offset:2112
    ds_read_b32 v10, v1 offset:2176
    ds_read_b32 v11, v1 offset:2240
    s_lshl_b32 s58, s2, 6
    s_add_u32 s58, s58, 0
    s_add_u32 s44, s18, s58
    s_addc_u32 s45, s19, 0
    s_and_b32 s45, s45, 0xffff
    s_mov_b32 s46, 64
    s_mov_b32 s47, 0x20000
    s_waitcnt lgkmcnt(0)
    v_add_f32 v8, v8, v9
    v_add_f32 v8, v8, v10
    v_add_f32 v8, v8, v11
    buffer_store_dword v8, v1, s[44:47], 0 offen sc1
    s_waitcnt vmcnt(0)
    s_lshl_b32 s58, s39, 2
    s_add_u32 s58, s58, 128
    v_mov_b32 v5, s58
    v_mov_b32 v6, 1
    s_mov_b64 exec, 1
    global_atomic_add v5, v6, s[16:17]
    s_mov_b64 exec, -1
    v_mov_b32 v3, 2376
L_c_wl:
    s_sleep 8
    ds_read_b32 v7, v3
    s_waitcnt lgkmcnt(0)
    v_readfirstlane_b32 s58, v7
    s_nop 3
    s_cmp_eq_u32 s58, 0
    s_cbranch_scc1 L_c_wl
L_c_w8:
    global_load_dword v7, v5, s[16:17] sc1
    s_waitcnt vmcnt(0)
    v_readfirstlane_b32 s58, v7
    s_nop 3
    s_and_b32 s58, s58, 0xffff
    s_cmp_ge_u32 s58, 8
    s_cbranch_scc1 L_c_k8
    s_sleep 8
    s_branch L_c_w8
L_c_k8:
    s_lshl_b32 s58, s39, 9
    s_add_u32 s58, s58, 0
    s_add_u32 s44, s18, s58
    s_addc_u32 s45, s19, 0
    s_and_b32 s45, s45, 0xffff
    s_mov_b32 s46, 512
    s_mov_b32 s47, 0x20000
    buffer_load_dword v8, v1, s[44:47], 0 offen sc1
    buffer_load_dword v9, v1, s[44:47], 0 offen offset:256 sc1
    s_mov_b32 s59, 0x3e0293ee
    s_waitcnt vmcnt(0)
    v_add_f32 v8, v8, v9
    v_mov_b32 v9, v8
    s_nop 1
    v_permlane32_swap_b32 v8, v9
    s_nop 1
    v_add_f32 v8, v8, v9
    v_mov_b32 v9, v8
    s_nop 1
    v_permlane16_swap_b32 v8, v9
    s_nop 1
    v_add_f32 v8, v8, v9
    v_mul_f32 v8, s59, v8
    v_mov_b32 v9, v8
    s_nop 1
    v_max_f32_dpp v9, v9, v9 row_ror:8 row_mask:0xf bank_mask:0xf
    s_nop 1
    v_max_f32_dpp v9, v9, v9 row_ror:4 row_mask:0xf bank_mask:0xf
    s_nop 1
    v_max_f32_dpp v9, v9, v9 row_ror:2 row_mask:0xf bank_mask:0xf
    s_nop 1
    v_max_f32_dpp v9, v9, v9 row_ror:1 row_mask:0xf bank_mask:0xf
    v_sub_f32 v8, v8, v9
    v_exp_f32 v8, v8
    s_nop 0
    v_mov_b32 v9, v8
    s_nop 1
    v_add_f32_dpp v9, v9, v9 row_ror:8 row_mask:0xf bank_mask:0xf
    s_nop 1
    v_add_f32_dpp v9, v9, v9 row_ror:4 row_mask:0xf bank_mask:0xf
    s_nop 1
    v_add_f32_dpp v9, v9, v9 row_ror:2 row_mask:0xf bank_mask:0xf
    s_nop 1
    v_add_f32_dpp v9, v9, v9 row_ror:1 row_mask:0xf bank_mask:0xf
    v_rcp_f32 v9, v9
    s_nop 0
    v_mul_f32 v8, v8, v9
    s_mov_b64 exec, 0xffff
    ds_write_b32 v1, v8 offset:2304
    s_waitcnt lgkmcnt(0)
    s_mov_b64 exec, 1
    v_mov_b32 v9, 2372
    ds_write_b32 v9, v6
    s_mov_b64 exec, -1
    s_mov_b32 s53, 2
    s_mov_b32 s57, 0
    s_mov_b32 s60, 0
    v_mov_b32 v3, 2376
    v_mov_b32 v10, 2432
    s_mov_b32 s24, s42
    s_mov_b32 s32, 2
    s_mov_b32 s33, 0
L_c_claim:
    ds_read_b32 v16, v3
    s_waitcnt lgkmcnt(0)
    v_readfirstlane_b32 s58, v16
    s_nop 3
    s_cmp_ge_u32 s58, s53
    s_cbranch_scc1 L_c_go
    s_sleep 1
    s_branch L_c_claim
L_c_go:
    s_mov_b64 exec, 1
    v_mov_b32 v17, s32
    global_atomic_add v7, v4, v17, s[18:19] sc0
    s_waitcnt vmcnt(0)
    s_mov_b64 exec, -1
    v_readfirstlane_b32 s25, v7
    s_nop 3
    s_cmp_ge_u32 s25, 64
    s_cbranch_scc1 L_c_alldone
    s_add_u32 s26, s25, s32
    s_min_u32 s26, s26, 64
L_c_pub:
    s_and_b32 s58, s25, 7
    s_lshl_b32 s58, s58, 21
    s_lshr_b32 s59, s25, 3
    s_add_u32 s59, s59, 56
    s_lshl_b32 s59, s59, 15
    s_add_u32 s58, s58, s59
    v_mov_b32 v7, s58
    s_mov_b64 exec, 1
    ds_write_b32 v10, v7
    s_mov_b64 exec, -1
    v_add_u32 v10, 4, v10
    s_add_u32 s53, s53, 1
    s_add_u32 s25, s25, 1
    s_cmp_lt_u32 s25, s26
    s_cbranch_scc1 L_c_pub
    s_sub_u32 s25, s25, 1
    s_cmp_lt_u32 s25, 40
    s_cselect_b32 s32, 2, 1
    s_cmp_ge_u32 s25, 63
    s_cbranch_scc1 L_c_alldone
    s_cmp_lt_u32 s25, 48
    s_cbranch_scc1 L_c_claim
    s_sub_u32 s59, s53, 2
L_c_lazy:
    ds_read_b32 v16, v3 offset:4
    s_waitcnt lgkmcnt(0)
    v_readfirstlane_b32 s58, v16
    s_nop 3
    s_cmp_ge_u32 s58, s59
    s_cbranch_scc1 L_c_go
    s_sleep 1
    s_branch L_c_lazy
L_c_alldone:
    v_mov_b32 v7, 1073741824
    s_mov_b64 exec, 1
    ds_write_b32 v10, v7
    s_mov_b64 exec, -1
    s_waitcnt lgkmcnt(0)
    s_barrier
    v_lshlrev_b32 v2, 3, v0
    ds_read_b64 v[8:9], v2 offset:0
    ds_read_b64 v[10:11], v2 offset:512
    ds_read_b64 v[12:13], v2 offset:1024
    ds_read_b64 v[14:15], v2 offset:1536
    s_lshl_b32 s58, s2, 9
    s_add_u32 s58, s58, 65536
    s_add_u32 s44, s18, s58
    s_addc_u32 s45, s19, 0
    s_and_b32 s45, s45, 0xffff
    s_mov_b32 s46, 512
    s_mov_b32 s47, 0x20000
    s_waitcnt lgkmcnt(0)
    v_add_f32 v8, v8, v10
    v_add_f32 v9, v9, v11
    v_add_f32 v8, v8, v12
    v_add_f32 v9, v9, v13
    v_add_f32 v8, v8, v14
    v_add_f32 v9, v9, v15
    v_cmp_eq_u32 vcc, -1, v8
    v_cmp_eq_u32 s[48:49], -1, v9
    v_mov_b32 v20, 0x7fc00000
    s_nop 0
    v_cndmask_b32 v8, v8, v20, vcc
    v_cndmask_b32 v9, v9, v20, s[48:49]
    v_mov_b32 v31, 0x10000
    buffer_store_dwordx2 v[8:9], v2, s[44:47], 0 offen sc1
    s_mov_b64 exec, 1
    global_atomic_add v7, v5, v31, s[16:17] sc0
    s_mov_b64 exec, -1
    s_lshl_b32 s58, s39, 12
    s_add_u32 s58, s58, 65536
    s_add_u32 s44, s18, s58
    s_addc_u32 s45, s19, 0
    s_and_b32 s45, s45, 0xffff
    s_mov_b32 s46, 4096
    s_mov_b32 s47, 0x20000
    s_cmp_eq_u32 s42, 0
    s_cselect_b32 s59, 1073741824, 0
    buffer_load_dwordx2 v[10:11], v2, s[44:47], s59 offen sc1
    s_cmp_eq_u32 s42, 1
    s_cselect_b32 s59, 1073741824, 512
    buffer_load_dwordx2 v[12:13], v2, s[44:47], s59 offen sc1
    s_cmp_eq_u32 s42, 2
    s_cselect_b32 s59, 1073741824, 1024
    buffer_load_dwordx2 v[14:15], v2, s[44:47], s59 offen sc1
    s_cmp_eq_u32 s42, 3
    s_cselect_b32 s59, 1073741824, 1536
    buffer_load_dwordx2 v[16:17], v2, s[44:47], s59 offen sc1
    s_cmp_eq_u32 s42, 4
    s_cselect_b32 s59, 1073741824, 2048
    buffer_load_dwordx2 v[18:19], v2, s[44:47], s59 offen sc1
    s_cmp_eq_u32 s42, 5
    s_cselect_b32 s59, 1073741824, 2560
    buffer_load_dwordx2 v[20:21], v2, s[44:47], s59 offen sc1
    s_cmp_eq_u32 s42, 6
    s_cselect_b32 s59, 1073741824, 3072
    buffer_load_dwordx2 v[22:23], v2, s[44:47], s59 offen sc1
    s_cmp_eq_u32 s42, 7
    s_cselect_b32 s59, 1073741824, 3584
    buffer_load_dwordx2 v[24:25], v2, s[44:47], s59 offen sc1
    s_lshl_b32 s58, s39, 8
    s_add_u32 s48, s14, s58
    s_addc_u32 s49, s15, 0
    s_and_b32 s49, s49, 0xffff
    s_mov_b32 s50, 256
    s_mov_b32 s51, 0x20000
    s_waitcnt vmcnt(0)
    v_readfirstlane_b32 s58, v7
    s_nop 3
    s_lshr_b32 s58, s58, 16
    s_cmp_lg_u32 s58, 7
    s_cbranch_scc1 L_c_notlast
L_c_check:
    v_max3_u32 v30, v10, v11, v12
    v_max3_u32 v30, v13, v14, v30
    v_max3_u32 v30, v15, v16, v30
    v_max3_u32 v30, v17, v18, v30
    v_max3_u32 v30, v19, v20, v30
    v_max3_u32 v30, v21, v22, v30
    v_max3_u32 v30, v23, v24, v30
    v_max_u32 v30, v25, v30
    v_cmp_eq_u32 vcc, -1, v30
    s_nop 4
    s_cbranch_vccz L_c_sum
    s_cmp_eq_u32 s42, 0
    s_cselect_b32 s59, 1073741824, 0
    buffer_load_dwordx2 v[10:11], v2, s[44:47], s59 offen sc1
    s_cmp_eq_u32 s42, 1
    s_cselect_b32 s59, 1073741824, 512
    buffer_load_dwordx2 v[12:13], v2, s[44:47], s59 offen sc1
    s_cmp_eq_u32 s42, 2
    s_cselect_b32 s59, 1073741824, 1024
    buffer_load_dwordx2 v[14:15], v2, s[44:47], s59 offen sc1
    s_cmp_eq_u32 s42, 3
    s_cselect_b32 s59, 1073741824, 1536
    buffer_load_dwordx2 v[16:17], v2, s[44:47], s59 offen sc1
    s_cmp_eq_u32 s42, 4
    s_cselect_b32 s59, 1073741824, 2048
    buffer_load_dwordx2 v[18:19], v2, s[44:47], s59 offen sc1
    s_cmp_eq_u32 s42, 5
    s_cselect_b32 s59, 1073741824, 2560
    buffer_load_dwordx2 v[20:21], v2, s[44:47], s59 offen sc1
    s_cmp_eq_u32 s42, 6
    s_cselect_b32 s59, 1073741824, 3072
    buffer_load_dwordx2 v[22:23], v2, s[44:47], s59 offen sc1
    s_cmp_eq_u32 s42, 7
    s_cselect_b32 s59, 1073741824, 3584
    buffer_load_dwordx2 v[24:25], v2, s[44:47], s59 offen sc1
    s_waitcnt vmcnt(0)
    s_branch L_c_check
L_c_sum:
    v_add_f32 v10, v10, v8
    v_add_f32 v11, v11, v9
    v_add_f32 v10, v10, v12
    v_add_f32 v11, v11, v13
    v_add_f32 v10, v10, v14
    v_add_f32 v11, v11, v15
    v_add_f32 v10, v10, v16
    v_add_f32 v11, v11, v17
    v_add_f32 v10, v10, v18
    v_add_f32 v11, v11, v19
    v_add_f32 v10, v10, v20
    v_add_f32 v11, v11, v21
    v_add_f32 v10, v10, v22
    v_add_f32 v11, v11, v23
    v_add_f32 v10, v10, v24
    v_add_f32 v11, v11, v25
    v_cvt_pk_bf16_f32 v10, v10, v11
    buffer_store_dword v10, v1, s[48:51], 0 offen
L_c_notlast:
L_end:
    s_endpgm
.section .rodata,"a"
.p2align 6
.amdhsa_kernel standalone__low_rank_proj_linformer__decode_kernel
  .amdhsa_next_free_vgpr 160
  .amdhsa_accum_offset 160
  .amdhsa_next_free_sgpr 64
  .amdhsa_group_segment_fixed_size 0
  .amdhsa_kernarg_size 64
  .amdhsa_user_sgpr_count 2
  .amdhsa_user_sgpr_kernarg_segment_ptr 1
  .amdhsa_system_sgpr_workgroup_id_x 1
.end_amdhsa_kernel
```
